```python
import torch

def _softmax(x, axis=-1):
    return torch.softmax(x, dim=axis)
def _gelu(x):
    return torch.nn.functional.gelu(x, approximate="tanh")
def _silu(x):
    return torch.nn.functional.silu(x)
def _sigmoid(x):
    return torch.sigmoid(x)
def _layernorm(x, axis=-1, eps=1e-5):
    m = x.mean(dim=axis, keepdim=True)
    v = x.var(dim=axis, keepdim=True, unbiased=False)
    return (x - m) / torch.sqrt(v + eps)
def _scatter_add(tgt, idx, src, axis=0):
    return tgt.clone().index_add_(axis, idx, src)
def _segment_sum(src, seg, n):
    out = torch.zeros((n,) + src.shape[1:], dtype=src.dtype)
    return out.index_add_(0, seg, src)
def _pad(x, pw):
    flat = tuple(v for pair in reversed(pw) for v in pair)
    return torch.nn.functional.pad(x, flat)

kernel_name = 'recurrent_scan__sliding_block_cached__swiglu_ffn__decode'

def setup_inputs():

    _w = (lambda a: (lambda t: t.to(torch.bfloat16) if t.is_floating_point() else t)(torch.as_tensor(a)))
    def _A_setup():
        B, Sq, D = 2, 1, 512
        Hq, Hkv, Sk, Dh = 32, 8, 32768, 128
        assert Hq % Hkv == 0, (Hq, Hkv)
        return {
            "x": _w((lambda *s: torch.randn(*s, dtype=torch.bfloat16) * 0.05)(B, Sq, D)),
            "k_cache": _w((lambda *s: torch.randn(*s, dtype=torch.bfloat16) * 1.6)(B, Hkv, Sk, Dh)),
            "v_cache": _w((lambda *s: torch.randn(*s, dtype=torch.bfloat16) * 0.2)(B, Hkv, Sk, Dh)),
            "wq": _w((lambda *s: torch.randn(*s, dtype=torch.bfloat16) * 1.6)(D, Hq * Dh) * (D ** -0.5)),
            "wo": _w((lambda *s: torch.randn(*s, dtype=torch.bfloat16) * 0.2)(Hq * Dh, D) * ((Hq * Dh) ** -0.5)),
        }
    _A_in = _A_setup()

    def _B_setup():
        B, S, D, F = 2, 1, 512, 1792
        return {
            "x": _w((lambda *s: torch.randn(*s, dtype=torch.bfloat16) * 0.05)(B, S, D)),
            "w_gate": _w((lambda *s: torch.randn(*s, dtype=torch.bfloat16) * 0.1)(D, F)),
            "w_up": _w((lambda *s: torch.randn(*s, dtype=torch.bfloat16) * 0.1)(D, F)),
            "w_down": _w((lambda *s: torch.randn(*s, dtype=torch.bfloat16) * 0.1)(F, D)),
        }
    _B_in = _B_setup()

    return {
        "A_x": _A_in["x"],
        "A_k_cache": _A_in["k_cache"],
        "A_v_cache": _A_in["v_cache"],
        "A_wq": _A_in["wq"],
        "A_wo": _A_in["wo"],
        "B_x": _B_in["x"],
        "B_w_gate": _B_in["w_gate"],
        "B_w_up": _B_in["w_up"],
        "B_w_down": _B_in["w_down"],
    }

def reference(A_x, A_k_cache, A_v_cache, A_wq, A_wo, B_x, B_w_gate, B_w_up, B_w_down):
    def _A_ref(x, k_cache, v_cache, wq, wo):
        B, Sq, D = x.shape
        Hq, Dh = 32, 128
        Hkv, Sk = k_cache.shape[1], k_cache.shape[2]
        W = min(4096, max(256, Sk // 4))
        rep = Hq // Hkv
        q = (lambda x, *d: x.permute(*d))((x @ wq).reshape(B, Sq, Hq, Dh), 0, 2, 1, 3)
        k = (lambda x, n, axis: torch.repeat_interleave(x, n, dim=axis))(k_cache[:, :, Sk - W:, :], rep, axis=1)
        v = (lambda x, n, axis: torch.repeat_interleave(x, n, dim=axis))(v_cache[:, :, Sk - W:, :], rep, axis=1)
        scores = torch.einsum("bhqd,bhkd->bhqk", q, k) * (Dh ** -0.5)
        p = _softmax(scores, axis=-1)
        o = torch.einsum("bhqk,bhkd->bhqd", p, v)
        return (lambda x, *d: x.permute(*d))(o, 0, 2, 1, 3).reshape(B, Sq, Hq * Dh) @ wo

    def _B_ref(x, w_gate, w_up, w_down):
        g = _silu(x @ w_gate)
        u = x @ w_up
        return (g * u) @ w_down

    x = A_x
    xn = _layernorm(x, axis=-1)
    s = _A_ref(xn, A_k_cache, A_v_cache, A_wq, A_wo)
    g = _silu(_B_ref(xn, B_w_gate, B_w_up, B_w_down))
    return x + s * g
```

```asm
; @launch grid=(256,1,1) block=(320,1,1) lds=163840
.amdgcn_target "amdgcn-amd-amdhsa--gfx950"
.text
.globl recurrent_scan__sliding_block_cached__swiglu_ffn__decode_kernel
.p2align 8
.type recurrent_scan__sliding_block_cached__swiglu_ffn__decode_kernel,@function
recurrent_scan__sliding_block_cached__swiglu_ffn__decode_kernel:
s_load_dwordx16 s[8:23], s[0:1], 0
s_load_dwordx8 s[24:31], s[0:1], 64
v_lshrrev_b32 v1, 6, v0
s_lshr_b32 s6, s2, 3
v_readfirstlane_b32 s4, v1
s_cmp_ge_u32 s6, 32
s_cbranch_scc1 L_end0
v_and_b32 v0, 63, v0
s_and_b32 s5, s2, 7
s_cmp_lg_u32 s4, 0
s_cbranch_scc1 L_disp
v_lshrrev_b32 v1, 4, v0
v_and_b32 v5, 15, v0
v_lshlrev_b32 v6, 8, v1
v_xor_b32 v7, v1, v5
v_lshl_add_u32 v12, v7, 4, v6
s_movk_i32 s3, 0x80
v_xor_b32 v13, 64, v12
v_xor_b32 v14, s3, v12
v_xor_b32 v15, s3, v13
s_lshr_b32 s3, s6, 4
s_lshl_b32 s34, s3, 26
s_lshl_b32 s3, s5, 3
s_or_b32 s3, s3, 7
s_lshl_b32 s3, s3, 20
s_add_u32 s34, s34, s3
s_and_b32 s3, s6, 15
s_lshl_b32 s3, s3, 16
s_add_u32 s34, s34, s3
s_lshl_b32 s38, 1, 16
s_mov_b32 s39, 0x20000
s_lshr_b32 s57, s6, 1
s_and_b32 s57, s57, 15
s_lshl_b32 s57, s57, 12
s_movk_i32 s61, 0x1000
s_mov_b32 m0, 0
s_mov_b32 s35, 0
s_waitcnt lgkmcnt(0)
s_add_u32 s36, s10, s34
s_addc_u32 s37, s11, 0
L_k0:
buffer_load_dwordx4 v12, s[36:39], s57 offen offset:0 nt lds
buffer_load_dwordx4 v13, s[36:39], s57 offen offset:1024 nt lds
buffer_load_dwordx4 v14, s[36:39], s57 offen offset:2048 nt lds
buffer_load_dwordx4 v15, s[36:39], s57 offen offset:3072 nt lds
s_add_u32 s57, s57, s61
s_bitset0_b32 s57, 16
s_add_u32 m0, m0, s61
s_sub_u32 s35, s35, 1
s_cbranch_scc0 L_k0
s_branch L_loader2
L_end0:
s_endpgm
.p2align 8
L_disp:
s_branch L_comp
L_loader2:
s_mov_b32 m0, 159232
s_mov_b32 s64, s8
s_mov_b32 s65, s9
s_movk_i32 s66, 0x800
s_mov_b32 s67, 0x20000
v_lshlrev_b32 v7, 4, v0
buffer_load_dwordx4 v7, s[64:67], 0 offen lds
buffer_load_dwordx4 v7, s[64:67], 0 offen offset:1024 lds
v_mov_b32 v8, 0
v_lshlrev_b32 v9, 2, v0
v_add_u32 v9, 161792, v9
ds_write_b32 v9, v8
v_lshlrev_b32 v7, 1, v1
v_xor_b32 v7, v7, v5
v_lshlrev_b32 v7, 4, v7
s_lshl_b32 s3, s5, 4
s_add_u32 s3, s3, s6
s_sub_u32 s3, s3, 16
s_lshr_b32 s58, s3, 3
s_bfe_u32 s7, s3, 0x20001
s_mulk_i32 s7, 1792
s_add_u32 s58, s58, s7
s_bitcmp0_b32 s3, 0
s_cselect_b32 s40, s20, s22
s_cselect_b32 s41, s21, s23
s_lshl_b32 s33, s5, 2
s_and_b32 s7, s6, 3
s_add_u32 s33, s33, s7
s_lshr_b32 s7, s6, 2
s_lshl_b32 s7, s7, 12
s_add_u32 s33, s33, s7
s_movk_i32 s56, 3584
s_cmp_lt_u32 s6, 16
s_cselect_b32 s58, s33, s58
s_cselect_b32 s56, 0x2000, s56
s_cselect_b32 s40, s14, s40
s_cselect_b32 s41, s15, s41
s_cselect_b32 s3, 0, s3
s_cmp_lt_u32 s3, 112
s_cselect_b32 s58, s58, 0
s_cselect_b32 s42, s56, 0
s_cselect_b32 s7, 1, 0
s_lshl_b32 s58, s58, 8
s_mulk_i32 s42, 127
s_lshl_b32 s7, s7, 8
s_add_u32 s42, s42, s7
s_add_u32 s40, s40, s58
s_addc_u32 s41, s41, 0
s_mov_b32 s43, 0x20000
s_lshl_b32 s32, s56, 2
s_sub_u32 s33, s32, 0x400
s_lshl_b32 s32, s32, 2
v_mad_u32_u24 v8, v1, s56, v7
v_xor_b32 v10, 0x80, v8
v_add_u32 v9, s33, v8
v_add_u32 v10, s33, v10
v_add_u32 v10, s33, v10
v_add_u32 v11, s33, v10
s_mov_b32 m0, 98304
s_mov_b32 s33, 0
buffer_load_dwordx4 v8, s[40:43], s33 offen offset:0 nt lds
buffer_load_dwordx4 v9, s[40:43], s33 offen offset:1024 nt lds
buffer_load_dwordx4 v10, s[40:43], s33 offen offset:2048 nt lds
buffer_load_dwordx4 v11, s[40:43], s33 offen offset:3072 nt lds
s_add_u32 s33, s33, s32
s_add_u32 m0, m0, s61
s_nop 0
buffer_load_dwordx4 v8, s[40:43], s33 offen offset:0 nt lds
buffer_load_dwordx4 v9, s[40:43], s33 offen offset:1024 nt lds
buffer_load_dwordx4 v10, s[40:43], s33 offen offset:2048 nt lds
buffer_load_dwordx4 v11, s[40:43], s33 offen offset:3072 nt lds
s_add_u32 s33, s33, s32
s_add_u32 m0, m0, s61
s_nop 0
buffer_load_dwordx4 v8, s[40:43], s33 offen offset:0 nt lds
buffer_load_dwordx4 v9, s[40:43], s33 offen offset:1024 nt lds
buffer_load_dwordx4 v10, s[40:43], s33 offen offset:2048 nt lds
buffer_load_dwordx4 v11, s[40:43], s33 offen offset:3072 nt lds
s_add_u32 s33, s33, s32
s_add_u32 m0, m0, s61
s_nop 0
buffer_load_dwordx4 v8, s[40:43], s33 offen offset:0 nt lds
buffer_load_dwordx4 v9, s[40:43], s33 offen offset:1024 nt lds
buffer_load_dwordx4 v10, s[40:43], s33 offen offset:2048 nt lds
buffer_load_dwordx4 v11, s[40:43], s33 offen offset:3072 nt lds
s_add_u32 s33, s33, s32
s_add_u32 m0, m0, s61
s_waitcnt lgkmcnt(0)
s_add_u32 s44, s12, s34
s_addc_u32 s45, s13, 0
s_mov_b32 s46, 0x10000
s_mov_b32 s47, 0x20000
s_load_dword s60, s[30:31], 0
s_and_b32 s3, s6, 1
s_lshl_b32 s3, s3, 3
s_add_u32 s3, s3, s5
s_lshl_b32 s3, s3, 4
s_lshr_b32 s7, s6, 1
s_add_u32 s3, s3, s7
s_lshl_b32 s3, s3, 3
s_load_dwordx2 s[62:63], s[8:9], s3
s_mov_b32 s68, 1000000
s_mov_b32 s10, 0x0c0c0400
s_mov_b32 s11, 0x04000c0c
v_add_u32 v16, v6, v7
v_xor_b32 v17, 0x80, v16
v_and_b32 v7, 1, v1
v_lshlrev_b32 v6, 2, v7
v_add_u32 v26, s3, v6
s_lshl_b32 s3, s5, 15
s_lshl_b32 s7, s6, 4
s_add_u32 s3, s3, s7
s_add_u32 s3, s3, 1048576
v_and_b32 v6, 31, v0
v_lshlrev_b32 v6, 9, v6
v_add_u32 v27, s3, v6
v_lshrrev_b32 v2, 3, v0
v_and_b32 v4, 7, v0
v_lshlrev_b32 v3, 1, v7
v_xor_b32 v3, v3, v4
v_lshlrev_b32 v3, 4, v3
v_lshl_add_u32 v20, v2, 10, v3
v_xor_b32 v21, 64, v20
v_add_u32 v21, 7168, v21
v_add_u32 v22, 14336, v20
v_add_u32 v23, 14336, v21
v_mov_b32 v24, 161792
v_mov_b32 v25, 1
s_lshr_b32 s3, s6, 3
s_lshl_b32 s7, s5, 2
s_add_u32 s3, s3, s7
s_lshl_b32 s3, s3, 17
s_and_b32 s7, s6, 7
s_lshl_b32 s7, s7, 7
s_add_u32 s3, s3, s7
s_add_u32 s48, s16, s3
s_addc_u32 s49, s17, 0
s_mov_b32 s50, 130176
s_mov_b32 s51, 0x20000
s_sub_u32 s3, s6, 4
s_cselect_b32 s3, 0, s3
s_cselect_b32 s54, 0, 64640
s_lshl_b32 s3, s3, 16
s_lshl_b32 s7, s5, 7
s_add_u32 s3, s3, s7
s_add_u32 s52, s24, s3
s_addc_u32 s53, s25, 0
s_mov_b32 s55, 0x20000
s_barrier
s_mov_b32 s35, 0
L_ld1:
s_waitcnt vmcnt(21)
buffer_load_dwordx4 v8, s[40:43], s33 offen offset:0 nt lds
s_waitcnt vmcnt(21)
buffer_load_dwordx4 v9, s[40:43], s33 offen offset:1024 nt lds
s_waitcnt vmcnt(21)
buffer_load_dwordx4 v10, s[40:43], s33 offen offset:2048 nt lds
s_waitcnt vmcnt(21)
buffer_load_dwordx4 v11, s[40:43], s33 offen offset:3072 nt lds
s_add_u32 s33, s33, s32
s_add_u32 m0, m0, s61
s_sub_u32 s35, s35, 1
s_cbranch_scc0 L_ld1
s_waitcnt vmcnt(20)
s_mov_b64 exec, 1
ds_write_b32 v24, v25 offset:92
s_mov_b64 exec, -1
s_mov_b32 s35, 2
L_ld2:
s_waitcnt vmcnt(21)
buffer_load_dwordx4 v8, s[40:43], s33 offen offset:0 nt lds
s_waitcnt vmcnt(21)
buffer_load_dwordx4 v9, s[40:43], s33 offen offset:1024 nt lds
s_waitcnt vmcnt(21)
buffer_load_dwordx4 v10, s[40:43], s33 offen offset:2048 nt lds
s_waitcnt vmcnt(21)
buffer_load_dwordx4 v11, s[40:43], s33 offen offset:3072 nt lds
s_add_u32 s33, s33, s32
s_add_u32 m0, m0, s61
s_sub_u32 s35, s35, 1
s_cbranch_scc0 L_ld2
s_mov_b32 s33, 0
s_mov_b32 m0, 147456
s_mov_b32 s35, 1
L_ld3:
s_waitcnt vmcnt(21)
buffer_load_dwordx4 v20, s[52:55], s33 offen offset:0 nt lds
s_waitcnt vmcnt(21)
buffer_load_dwordx4 v21, s[52:55], s33 offen offset:1024 nt lds
s_waitcnt vmcnt(21)
buffer_load_dwordx4 v22, s[52:55], s33 offen offset:2048 nt lds
s_waitcnt vmcnt(21)
buffer_load_dwordx4 v23, s[52:55], s33 offen offset:3072 nt lds
s_add_u32 s33, s33, 0x8000
s_add_u32 m0, m0, s61
s_sub_u32 s35, s35, 1
s_cbranch_scc0 L_ld3
s_mov_b32 s33, s57
s_mov_b32 m0, 4096
s_mov_b32 s35, 2
L_ld4:
s_waitcnt vmcnt(21)
buffer_load_dwordx4 v12, s[36:39], s33 offen offset:0 nt lds
s_waitcnt vmcnt(21)
buffer_load_dwordx4 v13, s[36:39], s33 offen offset:1024 nt lds
s_waitcnt vmcnt(21)
buffer_load_dwordx4 v14, s[36:39], s33 offen offset:2048 nt lds
s_waitcnt vmcnt(21)
buffer_load_dwordx4 v15, s[36:39], s33 offen offset:3072 nt lds
s_add_u32 s33, s33, s61
s_bitset0_b32 s33, 16
s_add_u32 m0, m0, s61
s_sub_u32 s35, s35, 1
s_cbranch_scc0 L_ld4
s_waitcnt vmcnt(20)
s_mov_b64 exec, 1
ds_write_b32 v24, v25 offset:80
s_mov_b64 exec, -1
s_mov_b32 s35, 11
L_ld5:
s_waitcnt vmcnt(21)
buffer_load_dwordx4 v12, s[36:39], s33 offen offset:0 nt lds
s_waitcnt vmcnt(21)
buffer_load_dwordx4 v13, s[36:39], s33 offen offset:1024 nt lds
s_waitcnt vmcnt(21)
buffer_load_dwordx4 v14, s[36:39], s33 offen offset:2048 nt lds
s_waitcnt vmcnt(21)
buffer_load_dwordx4 v15, s[36:39], s33 offen offset:3072 nt lds
s_add_u32 s33, s33, s61
s_bitset0_b32 s33, 16
s_add_u32 m0, m0, s61
s_sub_u32 s35, s35, 1
s_cbranch_scc0 L_ld5
s_mov_b32 s35, 4
L_ld6:
s_waitcnt vmcnt(21)
buffer_load_dwordx4 v16, s[44:47], s33 offen offset:0 nt lds
s_waitcnt vmcnt(21)
buffer_load_dwordx4 v16, s[44:47], s33 offen offset:1024 nt lds
s_waitcnt vmcnt(21)
buffer_load_dwordx4 v17, s[44:47], s33 offen offset:2048 nt lds
s_waitcnt vmcnt(21)
buffer_load_dwordx4 v17, s[44:47], s33 offen offset:3072 nt lds
s_add_u32 s33, s33, s61
s_bitset0_b32 s33, 16
s_add_u32 m0, m0, s61
s_sub_u32 s35, s35, 1
s_cbranch_scc0 L_ld6
s_waitcnt vmcnt(20)
s_mov_b64 exec, 1
ds_write_b32 v24, v25 offset:84
s_mov_b64 exec, -1
s_mov_b32 s35, 2
L_ld7:
s_waitcnt vmcnt(21)
buffer_load_dwordx4 v16, s[44:47], s33 offen offset:0 nt lds
s_waitcnt vmcnt(21)
buffer_load_dwordx4 v16, s[44:47], s33 offen offset:1024 nt lds
s_waitcnt vmcnt(21)
buffer_load_dwordx4 v17, s[44:47], s33 offen offset:2048 nt lds
s_waitcnt vmcnt(21)
buffer_load_dwordx4 v17, s[44:47], s33 offen offset:3072 nt lds
s_add_u32 s33, s33, s61
s_bitset0_b32 s33, 16
s_add_u32 m0, m0, s61
s_sub_u32 s35, s35, 1
s_cbranch_scc0 L_ld7
L_sp8:
ds_read_b128 v[28:31], v24 offset:0
s_waitcnt lgkmcnt(0)
v_and_b32 v28, v28, v29
v_and_b32 v30, v30, v31
v_and_b32 v28, v28, v30
v_cmp_ne_u32 vcc, 0, v28
s_cbranch_vccnz L_sp8_d
s_sleep 1
s_sub_u32 s68, s68, 1
s_cbranch_scc0 L_sp8
s_mov_b32 s68, 0
L_sp8_d:
s_mov_b32 s35, 7
L_ld9:
s_waitcnt vmcnt(21)
buffer_load_dwordx4 v16, s[44:47], s33 offen offset:0 nt lds
s_waitcnt vmcnt(21)
buffer_load_dwordx4 v16, s[44:47], s33 offen offset:1024 nt lds
s_waitcnt vmcnt(21)
buffer_load_dwordx4 v17, s[44:47], s33 offen offset:2048 nt lds
s_waitcnt vmcnt(21)
buffer_load_dwordx4 v17, s[44:47], s33 offen offset:3072 nt lds
s_add_u32 s33, s33, s61
s_bitset0_b32 s33, 16
s_add_u32 m0, m0, s61
s_sub_u32 s35, s35, 1
s_cbranch_scc0 L_ld9
s_mov_b32 s33, 0
s_mov_b32 m0, 131072
s_waitcnt vmcnt(21)
buffer_load_dwordx4 v20, s[48:51], s33 offen offset:0 nt lds
s_waitcnt vmcnt(21)
buffer_load_dwordx4 v21, s[48:51], s33 offen offset:1024 nt lds
s_waitcnt vmcnt(21)
buffer_load_dwordx4 v22, s[48:51], s33 offen offset:2048 nt lds
s_waitcnt vmcnt(21)
buffer_load_dwordx4 v23, s[48:51], s33 offen offset:3072 nt lds
s_add_u32 s33, s33, 0x8000
s_add_u32 m0, m0, s61
s_waitcnt vmcnt(21)
buffer_load_dwordx4 v20, s[48:51], s33 offen offset:0 nt lds
s_waitcnt vmcnt(21)
buffer_load_dwordx4 v21, s[48:51], s33 offen offset:1024 nt lds
s_waitcnt vmcnt(21)
buffer_load_dwordx4 v22, s[48:51], s33 offen offset:2048 nt lds
s_waitcnt vmcnt(21)
buffer_load_dwordx4 v23, s[48:51], s33 offen offset:3072 nt lds
s_waitcnt vmcnt(24)
s_mov_b64 exec, 1
ds_write_b32 v24, v25 offset:88
s_mov_b64 exec, -1
s_add_u32 s33, s33, 0x8000
s_add_u32 m0, m0, s61
s_waitcnt vmcnt(21)
buffer_load_dwordx4 v20, s[48:51], s33 offen offset:0 nt lds
s_waitcnt vmcnt(21)
buffer_load_dwordx4 v21, s[48:51], s33 offen offset:1024 nt lds
s_waitcnt vmcnt(21)
buffer_load_dwordx4 v22, s[48:51], s33 offen offset:2048 nt lds
s_waitcnt vmcnt(21)
buffer_load_dwordx4 v23, s[48:51], s33 offen offset:3072 nt lds
s_add_u32 s33, s33, 0x8000
s_add_u32 m0, m0, s61
s_waitcnt vmcnt(21)
buffer_load_dwordx4 v20, s[48:51], s33 offen offset:0 nt lds
s_waitcnt vmcnt(21)
buffer_load_dwordx4 v21, s[48:51], s33 offen offset:1024 nt lds
s_waitcnt vmcnt(21)
buffer_load_dwordx4 v22, s[48:51], s33 offen offset:2048 nt lds
s_waitcnt vmcnt(21)
buffer_load_dwordx4 v23, s[48:51], s33 offen offset:3072 nt lds
s_waitcnt vmcnt(16)
s_barrier
s_add_u32 s60, s60, 2654435769
s_mov_b32 s64, s30
s_mov_b32 s65, s31
s_mov_b32 s66, 1572864
s_mov_b32 s67, 0x20000
s_mov_b32 s34, 0x4000
s_mov_b32 s56, s26
s_mov_b32 s57, s27
s_movk_i32 s58, 0x800
s_mov_b32 s59, 0x20000
s_mov_b32 s24, s10
s_mov_b32 s25, s11
v_and_b32 v5, 1, v1
v_cmp_eq_u32 vcc, 1, v5
v_mov_b32 v2, s62
v_mov_b32 v3, s63
v_cndmask_b32 v2, v2, v3, vcc
v_lshlrev_b32 v28, 16, v2
v_and_b32 v29, 0xffff0000, v2
s_setprio 3
s_waitcnt vmcnt(0)
s_barrier
s_barrier
s_mov_b32 exec_hi, 0
buffer_load_dwordx4 v[36:39], v27, s[64:67], s34 offen sc1
s_barrier
buffer_load_dwordx4 v[32:35], v27, s[64:67], 0 offen sc1
s_branch L_pf_w
L_pf_r:
s_sub_u32 s68, s68, 1
s_cbranch_scc1 L_pf_x
s_mov_b64 exec, vcc
buffer_load_dwordx4 v[36:39], v27, s[64:67], s34 offen offset:0 sc1
s_mov_b32 exec_lo, -1
s_waitcnt vmcnt(0)
L_pf_w:
s_waitcnt vmcnt(1)
v_perm_b32 v40, v37, v36, s24
v_perm_b32 v41, v39, v38, s25
v_or_b32 v40, v40, v41
v_cmp_ne_u32 vcc, s60, v40
s_cbranch_vccnz L_pf_r
L_pf_d:
v_and_b32 v36, 0xffffff00, v36
v_and_b32 v37, 0xffffff00, v37
v_and_b32 v38, 0xffffff00, v38
v_and_b32 v39, 0xffffff00, v39
s_nop 0
v_permlane16_swap_b32 v36, v38
v_permlane16_swap_b32 v37, v39
v_pk_add_f32 v[36:37], v[36:37], v[38:39]
s_nop 1
v_add_f32_dpp v36, v36, v36 row_ror:8 row_mask:0xf bank_mask:0xf
v_add_f32_dpp v37, v37, v37 row_ror:8 row_mask:0xf bank_mask:0xf
s_nop 0
v_add_f32_dpp v36, v36, v36 row_ror:4 row_mask:0xf bank_mask:0xf
v_add_f32_dpp v37, v37, v37 row_ror:4 row_mask:0xf bank_mask:0xf
s_nop 0
v_add_f32_dpp v36, v36, v36 row_ror:2 row_mask:0xf bank_mask:0xf
v_add_f32_dpp v37, v37, v37 row_ror:2 row_mask:0xf bank_mask:0xf
s_nop 0
v_add_f32_dpp v36, v36, v36 row_ror:1 row_mask:0xf bank_mask:0xf
v_add_f32_dpp v37, v37, v37 row_ror:1 row_mask:0xf bank_mask:0xf
v_cvt_pk_bf16_f32 v37, v36, v37
v_lshlrev_b32 v36, 16, v37
v_and_b32 v37, 0xffff0000, v37
v_mul_f32 v38, 0xbfb8aa3b, v36
v_mul_f32 v39, 0xbfb8aa3b, v37
v_exp_f32 v38, v38
v_exp_f32 v39, v39
v_add_f32 v38, 1.0, v38
v_add_f32 v39, 1.0, v39
v_rcp_f32 v38, v38
v_rcp_f32 v39, v39
s_nop 0
v_pk_mul_f32 v[36:37], v[36:37], v[38:39]
v_cvt_pk_bf16_f32 v37, v36, v37
v_lshlrev_b32 v36, 16, v37
v_and_b32 v37, 0xffff0000, v37
s_branch L_ps_w
L_ps_r:
s_sub_u32 s68, s68, 1
s_cbranch_scc1 L_ps_x
s_mov_b64 exec, vcc
buffer_load_dwordx4 v[32:35], v27, s[64:67], 0 offen offset:0 sc1
s_mov_b32 exec_lo, -1
L_ps_w:
s_waitcnt vmcnt(0)
v_perm_b32 v40, v33, v32, s24
v_perm_b32 v41, v35, v34, s25
v_or_b32 v40, v40, v41
v_cmp_ne_u32 vcc, s60, v40
s_cbranch_vccnz L_ps_r
L_ps_d:
v_and_b32 v32, 0xffffff00, v32
v_and_b32 v33, 0xffffff00, v33
v_and_b32 v34, 0xffffff00, v34
v_and_b32 v35, 0xffffff00, v35
s_nop 0
v_permlane16_swap_b32 v32, v34
v_permlane16_swap_b32 v33, v35
v_pk_add_f32 v[32:33], v[32:33], v[34:35]
s_nop 1
v_add_f32_dpp v32, v32, v32 row_ror:8 row_mask:0xf bank_mask:0xf
v_add_f32_dpp v33, v33, v33 row_ror:8 row_mask:0xf bank_mask:0xf
s_nop 0
v_add_f32_dpp v32, v32, v32 row_ror:4 row_mask:0xf bank_mask:0xf
v_add_f32_dpp v33, v33, v33 row_ror:4 row_mask:0xf bank_mask:0xf
s_nop 0
v_add_f32_dpp v32, v32, v32 row_ror:2 row_mask:0xf bank_mask:0xf
v_add_f32_dpp v33, v33, v33 row_ror:2 row_mask:0xf bank_mask:0xf
s_nop 0
v_add_f32_dpp v32, v32, v32 row_ror:1 row_mask:0xf bank_mask:0xf
v_add_f32_dpp v33, v33, v33 row_ror:1 row_mask:0xf bank_mask:0xf
v_cvt_pk_bf16_f32 v33, v32, v33
v_lshlrev_b32 v32, 16, v33
v_and_b32 v33, 0xffff0000, v33
v_pk_mul_f32 v[32:33], v[32:33], v[36:37]
v_cvt_pk_bf16_f32 v33, v32, v33
v_lshlrev_b32 v32, 16, v33
v_and_b32 v33, 0xffff0000, v33
v_pk_add_f32 v[32:33], v[32:33], v[28:29]
s_mov_b32 exec_lo, 0x10001
v_cvt_pk_bf16_f32 v32, v32, v33
buffer_store_dword v32, v26, s[56:59], 0 offen
s_cmp_lg_u32 s2, 0
s_cbranch_scc1 L_lend
s_mov_b64 exec, 1
v_mov_b32 v1, 0
v_mov_b32 v2, s60
buffer_store_dword v2, v1, s[64:67], 0 offen
L_lend:
s_endpgm
L_comp:
s_barrier
s_setprio 2
s_sub_u32 s4, s4, 1
s_mov_b32 s46, 1572864
s_mov_b32 s47, 0x20000
s_waitcnt lgkmcnt(0)
s_load_dword s60, s[30:31], 0
s_mov_b32 s44, s30
s_mov_b32 s45, s31
s_mov_b32 s68, 1000000
s_getreg_b32 s63, hwreg(HW_REG_XCC_ID)
s_mov_b32 s24, 0x0c0c0400
s_mov_b32 s25, 0x04000c0c
s_mov_b32 s20, 0x07060500
s_mov_b32 s21, 0x07060501
s_mov_b32 s22, 0x07060502
s_mov_b32 s23, 0x07060503
s_cmp_lt_u32 s6, 16
s_cbranch_scc0 L_ffnunit
s_lshr_b32 s57, s6, 2
s_lshl_b32 s59, s5, 5
s_add_u32 s59, s59, s6
s_lshl_b32 s59, s59, 9
s_add_u32 s59, s59, 65536
s_movk_i32 s61, 0x2000
s_mov_b32 s58, -1
s_branch L_unitdone
L_ffnunit:
s_lshl_b32 s3, s5, 4
s_add_u32 s3, s3, s6
s_sub_u32 s3, s3, 16
s_bfe_u32 s57, s3, 0x20001
s_and_b32 s59, s3, 1
s_lshl_b32 s59, s59, 2
s_add_u32 s59, s59, s57
s_andn2_b32 s7, s3, 7
s_add_u32 s59, s59, s7
s_lshl_b32 s59, s59, 10
s_add_u32 s59, s59, 196608
s_movk_i32 s61, 512
s_mov_b32 s58, s3
s_cmp_lt_u32 s3, 112
s_cbranch_scc1 L_unitdone
s_mov_b32 s57, 0
s_mov_b32 s59, 311296
s_mov_b32 s58, -1
L_unitdone:
v_mov_b32 v8, 161792
v_lshrrev_b32 v18, 5, v0
v_and_b32 v5, 31, v0
v_lshlrev_b32 v2, 10, v18
v_lshl_add_u32 v2, v5, 5, v2
v_add_u32 v2, 159232, v2
s_lshl_b32 s3, s57, 8
v_lshlrev_b32 v1, 10, v18
v_lshl_add_u32 v1, v5, 3, v1
v_add_u32 v1, s3, v1
v_add_u32 v1, 159232, v1
v_mul_u32_u24 v3, 1088, v18
v_lshl_add_u32 v3, v5, 3, v3
v_add_u32 v3, 155648, v3
L_sp10:
ds_read_b32 v12, v8 offset:92
s_waitcnt lgkmcnt(0)
v_cmp_ne_u32 vcc, 0, v12
s_cbranch_vccnz L_sp10_d
s_sleep 1
s_sub_u32 s68, s68, 1
s_cbranch_scc0 L_sp10
s_mov_b32 s68, 0
L_sp10_d:
s_add_u32 s60, s60, 2654435769
s_and_b32 s63, s63, 15
s_cmp_lg_u32 s4, 0
s_cbranch_scc1 L_nox
s_lshl_b32 s3, s5, 5
s_add_u32 s3, s3, s6
s_lshl_b32 s3, s3, 3
s_add_u32 s3, s3, 8192
v_mov_b32 v4, s3
v_mov_b32 v6, s63
v_mov_b32 v7, s60
s_mov_b64 exec, 1
buffer_store_dwordx2 v[6:7], v4, s[44:47], 0 offen sc0
s_mov_b64 exec, -1
L_nox:
ds_read_b128 v[20:23], v2
ds_read_b128 v[24:27], v2 offset:16
ds_read_b64 v[16:17], v1
s_waitcnt lgkmcnt(1)
v_lshlrev_b32 v56, 16, v20
v_and_b32 v57, 0xffff0000, v20
v_lshlrev_b32 v58, 16, v21
v_and_b32 v59, 0xffff0000, v21
v_lshlrev_b32 v60, 16, v22
v_and_b32 v61, 0xffff0000, v22
v_lshlrev_b32 v62, 16, v23
v_and_b32 v63, 0xffff0000, v23
v_lshlrev_b32 v64, 16, v24
v_and_b32 v65, 0xffff0000, v24
v_lshlrev_b32 v66, 16, v25
v_and_b32 v67, 0xffff0000, v25
v_lshlrev_b32 v68, 16, v26
v_and_b32 v69, 0xffff0000, v26
v_lshlrev_b32 v70, 16, v27
v_and_b32 v71, 0xffff0000, v27
v_pk_add_f32 v[72:73], v[56:57], v[58:59]
v_pk_add_f32 v[74:75], v[60:61], v[62:63]
v_pk_add_f32 v[76:77], v[64:65], v[66:67]
v_pk_add_f32 v[78:79], v[68:69], v[70:71]
v_pk_add_f32 v[72:73], v[72:73], v[74:75]
v_pk_add_f32 v[76:77], v[76:77], v[78:79]
v_pk_add_f32 v[72:73], v[72:73], v[76:77]
v_add_f32 v12, v72, v73
v_mov_b32 v13, v12
s_nop 1
v_permlane16_swap_b32 v12, v13
v_add_f32 v12, v12, v13
s_nop 1
v_add_f32_dpp v12, v12, v12 row_ror:8 row_mask:0xf bank_mask:0xf
s_nop 1
v_add_f32_dpp v12, v12, v12 row_ror:4 row_mask:0xf bank_mask:0xf
s_nop 1
v_add_f32_dpp v12, v12, v12 row_ror:2 row_mask:0xf bank_mask:0xf
s_nop 1
v_add_f32_dpp v12, v12, v12 row_ror:1 row_mask:0xf bank_mask:0xf
v_mul_f32 v12, 0xbb000000, v12
v_pk_add_f32 v[56:57], v[56:57], v[12:13] op_sel_hi:[1,0]
v_pk_add_f32 v[58:59], v[58:59], v[12:13] op_sel_hi:[1,0]
v_pk_add_f32 v[60:61], v[60:61], v[12:13] op_sel_hi:[1,0]
v_pk_add_f32 v[62:63], v[62:63], v[12:13] op_sel_hi:[1,0]
v_pk_add_f32 v[64:65], v[64:65], v[12:13] op_sel_hi:[1,0]
v_pk_add_f32 v[66:67], v[66:67], v[12:13] op_sel_hi:[1,0]
v_pk_add_f32 v[68:69], v[68:69], v[12:13] op_sel_hi:[1,0]
v_pk_add_f32 v[70:71], v[70:71], v[12:13] op_sel_hi:[1,0]
v_pk_mul_f32 v[72:73], v[56:57], v[56:57]
v_pk_mul_f32 v[74:75], v[58:59], v[58:59]
v_pk_fma_f32 v[72:73], v[60:61], v[60:61], v[72:73]
v_pk_fma_f32 v[74:75], v[62:63], v[62:63], v[74:75]
v_pk_fma_f32 v[72:73], v[64:65], v[64:65], v[72:73]
v_pk_fma_f32 v[74:75], v[66:67], v[66:67], v[74:75]
v_pk_fma_f32 v[72:73], v[68:69], v[68:69], v[72:73]
v_pk_fma_f32 v[74:75], v[70:71], v[70:71], v[74:75]
v_pk_add_f32 v[72:73], v[72:73], v[74:75]
v_cvt_pk_bf16_f32 v12, v12, v12
v_add_f32 v14, v72, v73
v_lshlrev_b32 v12, 16, v12
v_mov_b32 v15, v14
s_nop 1
v_permlane16_swap_b32 v14, v15
v_add_f32 v14, v14, v15
s_nop 1
v_add_f32_dpp v14, v14, v14 row_ror:8 row_mask:0xf bank_mask:0xf
s_nop 1
v_add_f32_dpp v14, v14, v14 row_ror:4 row_mask:0xf bank_mask:0xf
s_nop 1
v_add_f32_dpp v14, v14, v14 row_ror:2 row_mask:0xf bank_mask:0xf
s_nop 1
v_add_f32_dpp v14, v14, v14 row_ror:1 row_mask:0xf bank_mask:0xf
v_mul_f32 v14, 0x3b000000, v14
s_waitcnt lgkmcnt(0)
v_cvt_pk_bf16_f32 v14, v14, v14
v_lshlrev_b32 v56, 16, v16
v_lshlrev_b32 v14, 16, v14
v_and_b32 v57, 0xffff0000, v16
v_add_f32 v14, 0x3727c5ac, v14
v_lshlrev_b32 v58, 16, v17
v_cvt_pk_bf16_f32 v14, v14, v14
v_and_b32 v59, 0xffff0000, v17
v_lshlrev_b32 v14, 16, v14
v_sqrt_f32 v14, v14
v_pk_add_f32 v[56:57], v[56:57], v[12:13] op_sel_hi:[1,0]
v_pk_add_f32 v[58:59], v[58:59], v[12:13] op_sel_hi:[1,0]
v_cvt_pk_bf16_f32 v14, v14, v14
v_cvt_pk_bf16_f32 v16, v56, v57
v_lshlrev_b32 v14, 16, v14
v_cvt_pk_bf16_f32 v17, v58, v59
v_rcp_f32 v14, v14
v_lshlrev_b32 v56, 16, v16
v_and_b32 v57, 0xffff0000, v16
v_lshlrev_b32 v58, 16, v17
v_and_b32 v59, 0xffff0000, v17
v_pk_mul_f32 v[56:57], v[56:57], v[14:15] op_sel_hi:[1,0]
v_pk_mul_f32 v[58:59], v[58:59], v[14:15] op_sel_hi:[1,0]
v_cvt_pk_bf16_f32 v16, v56, v57
v_cvt_pk_bf16_f32 v17, v58, v59
ds_write_b64 v3, v[16:17]
s_lshl_b32 s3, s4, 2
s_add_u32 s3, s3, 161792
v_mov_b32 v9, s3
v_mov_b32 v10, 1
v_lshrrev_b32 v1, 2, v0
v_and_b32 v2, 3, v0
v_lshrrev_b32 v3, 4, v0
v_and_b32 v7, 3, v1
v_lshl_add_u32 v7, v3, 3, v7
s_lshl_b32 s3, s4, 1
v_and_b32 v5, 7, v1
v_xor_b32 v5, s3, v5
v_lshlrev_b32 v6, 8, v7
v_lshl_add_u32 v6, v2, 3, v6
v_add_u32 v6, 65536, v6
v_lshl_add_u32 v29, v5, 5, v6
v_xor_b32 v30, 32, v29
v_lshlrev_b32 v6, 4, v3
v_and_b32 v4, 1, v0
v_mul_u32_u24 v5, 1088, v4
v_add_u32 v5, v5, v6
v_add_u32 v35, 155648, v5
s_lshl_b32 s3, s4, 7
s_add_u32 s3, s3, s59
v_mul_u32_u24 v5, s61, v4
v_add3_u32 v5, s3, v5, v6
v_bfe_u32 v4, v0, 1, 1
v_lshl_add_u32 v40, v4, 6, v5
v_cmp_eq_u32 s[64:65], 1, v4
ds_read_b128 v[152:155], v35 offset:0
ds_read_b128 v[156:159], v35 offset:64
ds_read_b128 v[160:163], v35 offset:128
ds_read_b128 v[164:167], v35 offset:192
v_mov_b32 v216, 0
v_mov_b32 v217, 0
v_mov_b32 v218, 0
v_mov_b32 v219, 0
v_mov_b32 v220, 0
v_mov_b32 v221, 0
v_mov_b32 v222, 0
v_mov_b32 v223, 0
v_mov_b32 v19, s60
L_sp11:
ds_read_b32 v12, v8 offset:80
s_waitcnt lgkmcnt(0)
v_cmp_ne_u32 vcc, 0, v12
s_cbranch_vccnz L_sp11_d
s_sleep 1
s_sub_u32 s68, s68, 1
s_cbranch_scc0 L_sp11
s_mov_b32 s68, 0
L_sp11_d:
ds_read_b64_tr_b16 v[88:89], v29 offset:32768
ds_read_b64_tr_b16 v[90:91], v29 offset:33792
ds_read_b64_tr_b16 v[92:93], v30 offset:32768
ds_read_b64_tr_b16 v[94:95], v30 offset:33792
ds_read_b64_tr_b16 v[96:97], v29 offset:40960
ds_read_b64_tr_b16 v[98:99], v29 offset:41984
ds_read_b64_tr_b16 v[100:101], v30 offset:40960
ds_read_b64_tr_b16 v[102:103], v30 offset:41984
ds_read_b64_tr_b16 v[104:105], v29 offset:49152
ds_read_b64_tr_b16 v[106:107], v29 offset:50176
ds_read_b64_tr_b16 v[108:109], v30 offset:49152
ds_read_b64_tr_b16 v[110:111], v30 offset:50176
ds_read_b64_tr_b16 v[112:113], v29 offset:57344
ds_read_b64_tr_b16 v[114:115], v29 offset:58368
ds_read_b64_tr_b16 v[116:117], v30 offset:57344
ds_read_b64_tr_b16 v[118:119], v30 offset:58368
s_waitcnt lgkmcnt(14)
v_mfma_f32_16x16x32_bf16 v[216:219], v[88:91], v[152:155], v[216:219]
s_waitcnt lgkmcnt(12)
v_mfma_f32_16x16x32_bf16 v[220:223], v[92:95], v[152:155], v[220:223]
s_waitcnt lgkmcnt(10)
v_mfma_f32_16x16x32_bf16 v[216:219], v[96:99], v[156:159], v[216:219]
s_waitcnt lgkmcnt(8)
v_mfma_f32_16x16x32_bf16 v[220:223], v[100:103], v[156:159], v[220:223]
s_waitcnt lgkmcnt(6)
v_mfma_f32_16x16x32_bf16 v[216:219], v[104:107], v[160:163], v[216:219]
s_waitcnt lgkmcnt(4)
v_mfma_f32_16x16x32_bf16 v[220:223], v[108:111], v[160:163], v[220:223]
s_waitcnt lgkmcnt(2)
v_mfma_f32_16x16x32_bf16 v[216:219], v[112:115], v[164:167], v[216:219]
s_waitcnt lgkmcnt(0)
v_mfma_f32_16x16x32_bf16 v[220:223], v[116:119], v[164:167], v[220:223]
s_mov_b64 exec, 1
ds_write_b32 v9, v10 offset:0
s_mov_b64 exec, -1
s_nop 4
v_cndmask_b32 v216, v216, v220, s[64:65]
v_cndmask_b32 v217, v217, v221, s[64:65]
v_cndmask_b32 v218, v218, v222, s[64:65]
v_cndmask_b32 v219, v219, v223, s[64:65]
v_add_u32 v216, 0x80, v216
v_add_u32 v217, 0x80, v217
v_add_u32 v218, 0x80, v218
v_add_u32 v219, 0x80, v219
v_perm_b32 v216, v216, v19, s20
v_perm_b32 v217, v217, v19, s21
v_perm_b32 v218, v218, v19, s22
v_perm_b32 v219, v219, v19, s23
s_mov_b32 exec_lo, 0x000f000f
s_mov_b32 exec_hi, 0x000f000f
buffer_store_dwordx4 v[216:219], v40, s[44:47], 0 offen sc0
s_mov_b64 exec, -1
s_lshl_b32 s3, s5, 8
s_add_u32 s3, s3, 8192
v_and_b32 v4, 31, v0
v_lshlrev_b32 v4, 3, v4
v_add_u32 v224, s3, v4
buffer_load_dwordx2 v[226:227], v224, s[44:47], 0 offen sc1
v_lshrrev_b32 v1, 2, v0
v_and_b32 v2, 3, v0
v_lshrrev_b32 v3, 4, v0
v_and_b32 v4, 15, v0
v_bfe_u32 v5, v0, 3, 2
v_xor_b32 v5, s4, v5
v_lshlrev_b32 v5, 5, v5
v_and_b32 v7, 3, v1
v_lshl_add_u32 v7, v3, 3, v7
v_lshl_add_u32 v5, v7, 7, v5
v_lshl_add_u32 v5, v2, 3, v5
v_add_u32 v28, 131072, v5
s_lshl_b32 s3, s4, 14
v_lshlrev_b32 v6, 8, v4
v_add_u32 v6, s3, v6
v_xor_b32 v5, v3, v4
v_lshl_add_u32 v31, v5, 4, v6
v_xor_b32 v32, 64, v31
v_xor_b32 v33, 0x80, v31
v_xor_b32 v34, 0xc0, v31
v_lshlrev_b32 v6, 4, v3
v_and_b32 v15, 1, v0
v_and_b32 v5, 1, v1
v_mul_u32_u24 v7, 320, v15
v_add_u32 v7, v7, v6
v_add_u32 v36, 162048, v7
v_lshl_add_u32 v7, v15, 7, v6
v_add_u32 v37, 162816, v7
v_mul_u32_u24 v7, 320, v2
v_add_u32 v7, v7, v6
v_add_u32 v38, 157952, v7
v_mul_u32_u24 v7, 576, v2
v_add_u32 v7, v7, v6
v_add_u32 v39, 159232, v7
v_and_b32 v13, 1, v3
s_lshr_b32 s3, s58, 3
s_lshl_b32 s3, s3, 13
s_and_b32 s7, s58, 7
s_lshl_b32 s7, s7, 6
s_add_u32 s3, s3, s7
s_add_u32 s3, s3, 196608
v_lshlrev_b32 v7, 9, v1
v_lshl_add_u32 v7, v2, 4, v7
v_add_u32 v51, s3, v7
s_lshl_b32 s3, s58, 7
s_add_u32 s3, s3, 16384
v_lshlrev_b32 v7, 6, v5
v_lshl_add_u32 v7, v2, 4, v7
v_lshl_add_u32 v7, v13, 3, v7
v_add_u32 v52, s3, v7
s_sub_u32 s7, s6, 4
s_cselect_b32 s7, 0, s7
s_lshl_b32 s3, s7, 9
s_add_u32 s3, s3, 16384
v_lshlrev_b32 v7, 3, v0
v_add_u32 v42, s3, v7
v_bfe_u32 v7, v0, 3, 1
v_lshlrev_b32 v7, 7, v7
v_lshl_add_u32 v7, v3, 5, v7
v_and_b32 v17, 7, v0
v_lshl_add_u32 v7, v17, 2, v7
v_add_u32 v49, 162816, v7
s_lshr_b32 s7, s6, 4
s_lshl_b32 s3, s5, 1
s_add_u32 s3, s3, s7
s_lshl_b32 s3, s3, 4
s_add_u32 s3, s3, s4
s_lshl_b32 s3, s3, 9
s_add_u32 s3, s3, 65536
v_lshrrev_b32 v14, 5, v0
v_and_b32 v5, 31, v0
v_lshlrev_b32 v7, 11, v14
v_lshl_add_u32 v7, v5, 4, v7
v_add_u32 v41, s3, v7
s_mul_i32 s3, s4, 320
s_add_u32 s3, s3, 157952
v_lshlrev_b32 v7, 2, v14
v_lshl_add_u32 v7, v5, 3, v7
v_add_u32 v46, s3, v7
v_bfe_u32 v6, v0, 3, 1
v_and_b32 v7, 7, v0
s_lshr_b32 s3, s6, 3
s_lshl_b32 s7, s5, 2
s_add_u32 s66, s3, s7
s_lshl_b32 s3, s66, 14
s_lshl_b32 s7, s4, 7
s_add_u32 s3, s3, s7
s_add_u32 s3, s3, 524288
v_lshlrev_b32 v5, 13, v6
v_lshl_add_u32 v5, v3, 11, v5
v_lshl_add_u32 v5, v7, 4, v5
v_add_u32 v44, s3, v5
s_lshl_b32 s3, s4, 6
s_add_u32 s3, s3, 162048
v_mul_u32_u24 v5, 320, v6
v_lshl_add_u32 v5, v7, 3, v5
v_lshl_add_u32 v5, v13, 2, v5
v_lshl_add_u32 v5, v14, 1, v5
v_add_u32 v50, s3, v5
s_lshl_b32 s3, s5, 16
s_lshl_b32 s7, s6, 9
s_add_u32 s3, s3, s7
s_lshl_b32 s7, s4, 7
s_add_u32 s3, s3, s7
s_add_u32 s3, s3, 524288
v_lshlrev_b32 v5, 14, v2
v_and_b32 v6, 1, v1
v_lshl_add_u32 v5, v6, 6, v5
v_lshl_add_u32 v5, v3, 4, v5
v_add_u32 v43, s3, v5
s_lshl_b32 s3, s4, 7
s_add_u32 s3, s3, 159232
v_mul_u32_u24 v5, 576, v2
v_and_b32 v6, 3, v1
v_lshl_add_u32 v5, v6, 5, v5
v_lshl_add_u32 v5, v3, 3, v5
v_add_u32 v47, s3, v5
v_lshlrev_b32 v5, 2, v2
v_add_u32 v48, 163072, v5
s_and_b32 s3, s6, 7
s_lshl_b32 s3, s3, 6
s_add_u32 s3, s3, s66
s_lshl_b32 s66, s3, 9
s_add_u32 s7, s6, 28
s_and_b32 s7, s7, 31
s_lshl_b32 s67, s5, 6
s_add_u32 s7, s7, s67
s_add_u32 s7, s7, 32
s_lshl_b32 s67, s7, 9
s_lshl_b32 s3, s4, 7
s_add_u32 s3, s3, 1048576
v_lshlrev_b32 v5, 5, v3
v_lshl_add_u32 v5, v15, 4, v5
v_add_u32 v45, s3, v5
v_mov_b32 v152, 0
v_mov_b32 v153, 0
v_mov_b32 v154, 0
v_mov_b32 v155, 0
v_mov_b32 v156, 0
v_mov_b32 v157, 0
v_mov_b32 v158, 0
v_mov_b32 v159, 0
v_mov_b32 v160, 0
v_mov_b32 v161, 0
v_mov_b32 v162, 0
v_mov_b32 v163, 0
v_mov_b32 v164, 0
v_mov_b32 v165, 0
v_mov_b32 v166, 0
v_mov_b32 v167, 0
v_mov_b32 v168, 0
v_mov_b32 v169, 0
v_mov_b32 v170, 0
v_mov_b32 v171, 0
v_mov_b32 v172, 0
v_mov_b32 v173, 0
v_mov_b32 v174, 0
v_mov_b32 v175, 0
v_mov_b32 v176, 0
v_mov_b32 v177, 0
v_mov_b32 v178, 0
v_mov_b32 v179, 0
v_mov_b32 v180, 0
v_mov_b32 v181, 0
v_mov_b32 v182, 0
v_mov_b32 v183, 0
v_mov_b32 v184, 0
v_mov_b32 v185, 0
v_mov_b32 v186, 0
v_mov_b32 v187, 0
v_mov_b32 v188, 0
v_mov_b32 v189, 0
v_mov_b32 v190, 0
v_mov_b32 v191, 0
v_mov_b32 v192, 0
v_mov_b32 v193, 0
v_mov_b32 v194, 0
v_mov_b32 v195, 0
v_mov_b32 v196, 0
v_mov_b32 v197, 0
v_mov_b32 v198, 0
v_mov_b32 v199, 0
v_mov_b32 v200, 0
v_mov_b32 v201, 0
v_mov_b32 v202, 0
v_mov_b32 v203, 0
v_mov_b32 v204, 0
v_mov_b32 v205, 0
v_mov_b32 v206, 0
v_mov_b32 v207, 0
v_mov_b32 v208, 0
v_mov_b32 v209, 0
v_mov_b32 v210, 0
v_mov_b32 v211, 0
v_mov_b32 v212, 0
v_mov_b32 v213, 0
v_mov_b32 v214, 0
v_mov_b32 v215, 0
s_movk_i32 s34, 0x1000
s_cmp_lg_u32 s4, 0
s_cselect_b32 s58, -1, s58
s_cmp_lt_i32 s58, 0
s_cbranch_scc1 L_nored0
buffer_load_dwordx4 v[228:231], v51, s[44:47], 0 offen sc1
L_nored0:
buffer_load_dwordx4 v[56:59], v41, s[44:47], 0 offen sc1
buffer_load_dwordx4 v[60:63], v41, s[44:47], s34 offen sc1
s_mov_b32 s7, 3
s_waitcnt vmcnt(2)
L_px:
v_cmp_ne_u32 vcc, s60, v227
s_cbranch_vccz L_px_d
buffer_load_dwordx2 v[226:227], v224, s[44:47], 0 offen sc1
s_sub_u32 s7, s7, 1
s_waitcnt vmcnt(0)
s_cbranch_scc0 L_px
s_mov_b32 s63, -1
L_px_d:
v_cmp_ne_u32 vcc, s63, v226
s_nop 0
s_cmp_eq_u64 vcc, 0
s_cselect_b32 s62, 0, 1
s_cmp_eq_u32 s62, 0
s_cbranch_scc1 L_p1done
s_mov_b32 exec_lo, 0x000f000f
s_mov_b32 exec_hi, 0x000f000f
buffer_store_dwordx4 v[216:219], v40, s[44:47], 0 offen sc1
s_mov_b64 exec, -1
L_p1done:
s_branch L_pq_w
L_pq_r:
s_sub_u32 s68, s68, 1
s_cbranch_scc1 L_pq_x
s_mov_b64 exec, s[8:9]
s_cbranch_execz L_pq_s0
buffer_load_dwordx4 v[56:59], v41, s[44:47], 0 offen offset:0 sc1
L_pq_s0:
s_mov_b64 exec, s[10:11]
s_cbranch_execz L_pq_s1
buffer_load_dwordx4 v[60:63], v41, s[44:47], s34 offen offset:0 sc1
L_pq_s1:
s_mov_b64 exec, -1
L_pq_w:
s_waitcnt vmcnt(0)
v_perm_b32 v12, v57, v56, s24
v_perm_b32 v13, v59, v58, s25
v_or_b32 v12, v12, v13
v_cmp_ne_u32 s[8:9], s60, v12
v_perm_b32 v12, v61, v60, s24
v_perm_b32 v13, v63, v62, s25
v_or_b32 v12, v12, v13
v_cmp_ne_u32 s[10:11], s60, v12
s_nop 0
s_or_b64 s[16:17], s[8:9], s[10:11]
s_cbranch_scc1 L_pq_r
L_pq_d:
v_and_b32 v56, 0xffffff00, v56
v_and_b32 v57, 0xffffff00, v57
v_and_b32 v58, 0xffffff00, v58
v_and_b32 v59, 0xffffff00, v59
v_and_b32 v60, 0xffffff00, v60
v_and_b32 v61, 0xffffff00, v61
v_and_b32 v62, 0xffffff00, v62
v_and_b32 v63, 0xffffff00, v63
v_pk_add_f32 v[56:57], v[56:57], v[60:61]
v_pk_add_f32 v[58:59], v[58:59], v[62:63]
s_nop 1
v_permlane32_swap_b32 v56, v58
v_permlane32_swap_b32 v57, v59
v_pk_add_f32 v[56:57], v[56:57], v[58:59]
v_cvt_pk_bf16_f32 v56, v56, v57
ds_write_b32 v46, v56
s_waitcnt lgkmcnt(0)
s_mov_b64 exec, 1
ds_write_b32 v9, v10 offset:16
s_mov_b64 exec, -1
s_cmp_lt_i32 s58, 0
s_cbranch_scc1 L_nored
s_branch L_pr_w
L_pr_r:
s_sub_u32 s68, s68, 1
s_cbranch_scc1 L_pr_x
s_mov_b64 exec, vcc
buffer_load_dwordx4 v[228:231], v51, s[44:47], 0 offen offset:0 sc1
s_mov_b64 exec, -1
L_pr_w:
s_waitcnt vmcnt(0)
v_perm_b32 v12, v229, v228, s24
v_perm_b32 v13, v231, v230, s25
v_or_b32 v12, v12, v13
v_cmp_ne_u32 vcc, s60, v12
s_cbranch_vccnz L_pr_r
L_pr_d:
v_and_b32 v228, 0xffffff00, v228
v_and_b32 v229, 0xffffff00, v229
v_and_b32 v230, 0xffffff00, v230
v_and_b32 v231, 0xffffff00, v231
v_add_f32_dpp v228, v228, v228 row_ror:8 row_mask:0xf bank_mask:0xf
v_add_f32_dpp v229, v229, v229 row_ror:8 row_mask:0xf bank_mask:0xf
v_add_f32_dpp v230, v230, v230 row_ror:8 row_mask:0xf bank_mask:0xf
v_add_f32_dpp v231, v231, v231 row_ror:8 row_mask:0xf bank_mask:0xf
s_nop 0
v_permlane16_swap_b32 v228, v230
v_permlane16_swap_b32 v229, v231
v_pk_add_f32 v[228:229], v[228:229], v[230:231]
v_cvt_pk_bf16_f32 v228, v228, v229
v_mov_b32 v229, v228
s_nop 1
v_permlane32_swap_b32 v228, v229
v_lshlrev_b32 v12, 16, v228
v_and_b32 v13, 0xffff0000, v228
v_mul_f32 v14, 0xbfb8aa3b, v12
v_mul_f32 v15, 0xbfb8aa3b, v13
v_exp_f32 v14, v14
v_exp_f32 v15, v15
v_lshlrev_b32 v230, 16, v229
v_add_f32 v14, 1.0, v14
v_add_f32 v15, 1.0, v15
v_rcp_f32 v14, v14
v_rcp_f32 v15, v15
v_and_b32 v231, 0xffff0000, v229
v_mul_f32 v12, v12, v14
v_mul_f32 v13, v13, v15
v_cvt_pk_bf16_f32 v12, v12, v13
v_and_b32 v13, 0xffff0000, v12
v_lshlrev_b32 v12, 16, v12
v_mul_f32 v12, v12, v230
v_mul_f32 v13, v13, v231
v_cvt_pk_bf16_f32 v12, v12, v13
v_mov_b32 v13, s60
s_mov_b32 exec_lo, 0x00ff00ff
s_mov_b32 exec_hi, 0
buffer_store_dwordx2 v[12:13], v52, s[44:47], 0 offen sc1
s_mov_b64 exec, -1
L_nored:
L_sp12:
ds_read_b128 v[12:15], v8 offset:16
s_waitcnt lgkmcnt(0)
v_and_b32 v12, v12, v13
v_and_b32 v14, v14, v15
v_and_b32 v12, v12, v14
v_cmp_ne_u32 vcc, 0, v12
s_cbranch_vccnz L_sp12_d
s_sleep 1
s_sub_u32 s68, s68, 1
s_cbranch_scc0 L_sp12
s_mov_b32 s68, 0
L_sp12_d:
s_mov_b32 exec_lo, 983055
s_mov_b32 exec_hi, 983055
ds_read_b128 v[152:155], v38 offset:0
ds_read_b128 v[156:159], v38 offset:64
ds_read_b128 v[160:163], v38 offset:128
ds_read_b128 v[164:167], v38 offset:192
s_mov_b32 exec_lo, 15728880
s_mov_b32 exec_hi, 15728880
ds_read_b128 v[168:171], v38 offset:0
ds_read_b128 v[172:175], v38 offset:64
ds_read_b128 v[176:179], v38 offset:128
ds_read_b128 v[180:183], v38 offset:192
s_mov_b32 exec_lo, 251662080
s_mov_b32 exec_hi, 251662080
ds_read_b128 v[184:187], v38 offset:0
ds_read_b128 v[188:191], v38 offset:64
ds_read_b128 v[192:195], v38 offset:128
ds_read_b128 v[196:199], v38 offset:192
s_mov_b32 exec_lo, 4026593280
s_mov_b32 exec_hi, 4026593280
ds_read_b128 v[200:203], v38 offset:0
ds_read_b128 v[204:207], v38 offset:64
ds_read_b128 v[208:211], v38 offset:128
ds_read_b128 v[212:215], v38 offset:192
s_mov_b64 exec, -1
v_mov_b32 v216, 0
v_mov_b32 v217, 0
v_mov_b32 v218, 0
v_mov_b32 v219, 0
L_sp13:
ds_read_b32 v12, v8 offset:84
s_waitcnt lgkmcnt(0)
v_cmp_ne_u32 vcc, 0, v12
s_cbranch_vccnz L_sp13_d
s_sleep 1
s_sub_u32 s68, s68, 1
s_cbranch_scc0 L_sp13
s_mov_b32 s68, 0
L_sp13_d:
ds_read_b128 v[88:91], v31 offset:0
ds_read_b128 v[92:95], v32 offset:0
ds_read_b128 v[96:99], v33 offset:0
ds_read_b128 v[100:103], v34 offset:0
ds_read_b128 v[104:107], v31 offset:4096
ds_read_b128 v[108:111], v32 offset:4096
ds_read_b128 v[112:115], v33 offset:4096
ds_read_b128 v[116:119], v34 offset:4096
ds_read_b128 v[120:123], v31 offset:8192
ds_read_b128 v[124:127], v32 offset:8192
ds_read_b128 v[128:131], v33 offset:8192
ds_read_b128 v[132:135], v34 offset:8192
ds_read_b128 v[136:139], v31 offset:12288
ds_read_b128 v[140:143], v32 offset:12288
ds_read_b128 v[144:147], v33 offset:12288
ds_read_b128 v[148:151], v34 offset:12288
s_waitcnt lgkmcnt(15)
v_mfma_f32_16x16x32_bf16 v[216:219], v[88:91], v[152:155], v[216:219]
s_waitcnt lgkmcnt(14)
v_mfma_f32_16x16x32_bf16 v[216:219], v[92:95], v[156:159], v[216:219]
s_waitcnt lgkmcnt(13)
v_mfma_f32_16x16x32_bf16 v[216:219], v[96:99], v[160:163], v[216:219]
s_waitcnt lgkmcnt(12)
v_mfma_f32_16x16x32_bf16 v[216:219], v[100:103], v[164:167], v[216:219]
s_waitcnt lgkmcnt(11)
v_mfma_f32_16x16x32_bf16 v[216:219], v[104:107], v[168:171], v[216:219]
s_waitcnt lgkmcnt(10)
v_mfma_f32_16x16x32_bf16 v[216:219], v[108:111], v[172:175], v[216:219]
s_waitcnt lgkmcnt(9)
v_mfma_f32_16x16x32_bf16 v[216:219], v[112:115], v[176:179], v[216:219]
s_waitcnt lgkmcnt(8)
v_mfma_f32_16x16x32_bf16 v[216:219], v[116:119], v[180:183], v[216:219]
s_waitcnt lgkmcnt(7)
v_mfma_f32_16x16x32_bf16 v[216:219], v[120:123], v[184:187], v[216:219]
s_waitcnt lgkmcnt(6)
v_mfma_f32_16x16x32_bf16 v[216:219], v[124:127], v[188:191], v[216:219]
s_waitcnt lgkmcnt(5)
v_mfma_f32_16x16x32_bf16 v[216:219], v[128:131], v[192:195], v[216:219]
s_waitcnt lgkmcnt(4)
v_mfma_f32_16x16x32_bf16 v[216:219], v[132:135], v[196:199], v[216:219]
s_waitcnt lgkmcnt(3)
v_mfma_f32_16x16x32_bf16 v[216:219], v[136:139], v[200:203], v[216:219]
s_waitcnt lgkmcnt(2)
v_mfma_f32_16x16x32_bf16 v[216:219], v[140:143], v[204:207], v[216:219]
s_waitcnt lgkmcnt(1)
v_mfma_f32_16x16x32_bf16 v[216:219], v[144:147], v[208:211], v[216:219]
s_waitcnt lgkmcnt(0)
v_mfma_f32_16x16x32_bf16 v[216:219], v[148:151], v[212:215], v[216:219]
v_mov_b32 v168, 0
v_mov_b32 v169, 0
v_mov_b32 v170, 0
v_mov_b32 v171, 0
v_mov_b32 v172, 0
v_mov_b32 v173, 0
v_mov_b32 v174, 0
v_mov_b32 v175, 0
v_cvt_pk_bf16_f32 v12, v216, v217
v_cvt_pk_bf16_f32 v13, v218, v219
v_lshlrev_b32 v232, 16, v12
v_and_b32 v233, 0xffff0000, v12
v_lshlrev_b32 v234, 16, v13
v_and_b32 v235, 0xffff0000, v13
v_mul_f32 v232, 0x3db504f3, v232
v_mul_f32 v233, 0x3db504f3, v233
v_mul_f32 v234, 0x3db504f3, v234
v_mul_f32 v235, 0x3db504f3, v235
v_cvt_pk_bf16_f32 v12, v232, v233
v_cvt_pk_bf16_f32 v13, v234, v235
v_lshlrev_b32 v232, 16, v12
v_and_b32 v233, 0xffff0000, v12
v_lshlrev_b32 v234, 16, v13
v_and_b32 v235, 0xffff0000, v13
v_max3_f32 v236, v232, v233, v234
v_max_f32 v236, v236, v235
s_nop 1
v_max_f32_dpp v236, v236, v236 row_ror:4 row_mask:0xf bank_mask:0xf
s_nop 1
v_max_f32_dpp v236, v236, v236 row_ror:8 row_mask:0xf bank_mask:0xf
v_mov_b32 v12, v236
s_nop 1
v_permlane16_swap_b32 v236, v12
v_max_f32 v236, v236, v12
v_mov_b32 v12, v236
s_nop 1
v_permlane32_swap_b32 v236, v12
v_max_f32 v236, v236, v12
s_lshl_b32 s3, s4, 4
v_add_u32 v16, s3, v48
s_mov_b64 exec, 15
ds_write_b32 v16, v236
s_mov_b64 exec, -1
s_waitcnt lgkmcnt(0)
s_mov_b64 exec, 1
ds_write_b32 v9, v10 offset:32
s_mov_b64 exec, -1
v_mov_b32 v176, 0
v_mov_b32 v177, 0
v_mov_b32 v178, 0
v_mov_b32 v179, 0
v_mov_b32 v180, 0
v_mov_b32 v181, 0
v_mov_b32 v182, 0
v_mov_b32 v183, 0
v_mov_b32 v184, 0
v_mov_b32 v185, 0
v_mov_b32 v186, 0
v_mov_b32 v187, 0
v_mov_b32 v188, 0
v_mov_b32 v189, 0
v_mov_b32 v190, 0
v_mov_b32 v191, 0
v_mov_b32 v192, 0
v_mov_b32 v193, 0
v_mov_b32 v194, 0
v_mov_b32 v195, 0
v_mov_b32 v196, 0
v_mov_b32 v197, 0
v_mov_b32 v198, 0
v_mov_b32 v199, 0
v_mov_b32 v200, 0
v_mov_b32 v201, 0
v_mov_b32 v202, 0
v_mov_b32 v203, 0
v_mov_b32 v204, 0
v_mov_b32 v205, 0
v_mov_b32 v206, 0
v_mov_b32 v207, 0
v_mov_b32 v208, 0
v_mov_b32 v209, 0
v_mov_b32 v210, 0
v_mov_b32 v211, 0
v_mov_b32 v212, 0
v_mov_b32 v213, 0
v_mov_b32 v214, 0
v_mov_b32 v215, 0
L_sp14:
ds_read_b128 v[12:15], v8 offset:32
s_waitcnt lgkmcnt(0)
v_and_b32 v12, v12, v13
v_and_b32 v14, v14, v15
v_and_b32 v12, v12, v14
v_cmp_ne_u32 vcc, 0, v12
s_cbranch_vccnz L_sp14_d
s_sleep 1
s_sub_u32 s68, s68, 1
s_cbranch_scc0 L_sp14
s_mov_b32 s68, 0
L_sp14_d:
ds_read2_b32 v[12:13], v48 offset0:0 offset1:4
ds_read2_b32 v[14:15], v48 offset0:8 offset1:12
s_waitcnt lgkmcnt(0)
v_max3_f32 v236, v12, v13, v14
v_max_f32 v236, v236, v15
v_sub_f32 v232, v232, v236
v_sub_f32 v233, v233, v236
v_sub_f32 v234, v234, v236
v_sub_f32 v235, v235, v236
v_mul_f32 v232, 0x3fb8aa3b, v232
v_mul_f32 v233, 0x3fb8aa3b, v233
v_mul_f32 v234, 0x3fb8aa3b, v234
v_mul_f32 v235, 0x3fb8aa3b, v235
v_exp_f32 v232, v232
v_exp_f32 v233, v233
v_exp_f32 v234, v234
v_exp_f32 v235, v235
v_add_f32 v237, v232, v233
v_add_f32 v12, v234, v235
v_cvt_pk_bf16_f32 v14, v232, v233
v_cvt_pk_bf16_f32 v15, v234, v235
v_add_f32 v237, v237, v12
ds_write_b64 v47, v[14:15]
s_nop 0
v_add_f32_dpp v237, v237, v237 row_ror:4 row_mask:0xf bank_mask:0xf
s_nop 1
v_add_f32_dpp v237, v237, v237 row_ror:8 row_mask:0xf bank_mask:0xf
v_mov_b32 v12, v237
s_nop 1
v_permlane16_swap_b32 v237, v12
v_add_f32 v237, v237, v12
v_mov_b32 v12, v237
s_nop 1
v_permlane32_swap_b32 v237, v12
v_add_f32 v237, v237, v12
s_mov_b64 exec, 15
ds_write_b32 v16, v237 offset:64
s_mov_b64 exec, -1
s_waitcnt lgkmcnt(0)
s_mov_b64 exec, 1
ds_write_b32 v9, v10 offset:48
s_mov_b64 exec, -1
ds_read_b64_tr_b16 v[72:73], v28 offset:16384
ds_read_b64_tr_b16 v[74:75], v28 offset:16896
ds_read_b64_tr_b16 v[76:77], v28 offset:20480
ds_read_b64_tr_b16 v[78:79], v28 offset:20992
v_mov_b32 v216, 0
v_mov_b32 v217, 0
v_mov_b32 v218, 0
v_mov_b32 v219, 0
v_mov_b32 v220, 0
v_mov_b32 v221, 0
v_mov_b32 v222, 0
v_mov_b32 v223, 0
L_sp15:
ds_read_b128 v[12:15], v8 offset:48
s_waitcnt lgkmcnt(0)
v_and_b32 v12, v12, v13
v_and_b32 v14, v14, v15
v_and_b32 v12, v12, v14
v_cmp_ne_u32 vcc, 0, v12
s_cbranch_vccnz L_sp15_d
s_sleep 1
s_sub_u32 s68, s68, 1
s_cbranch_scc0 L_sp15
s_mov_b32 s68, 0
L_sp15_d:
ds_read2_b32 v[12:13], v48 offset0:16 offset1:20
ds_read2_b32 v[14:15], v48 offset0:24 offset1:28
s_mov_b32 exec_lo, 983055
s_mov_b32 exec_hi, 983055
ds_read_b128 v[152:155], v39 offset:0
ds_read_b128 v[156:159], v39 offset:64
ds_read_b128 v[160:163], v39 offset:128
ds_read_b128 v[164:167], v39 offset:192
ds_read_b128 v[168:171], v39 offset:256
ds_read_b128 v[172:175], v39 offset:320
ds_read_b128 v[176:179], v39 offset:384
ds_read_b128 v[180:183], v39 offset:448
s_mov_b32 exec_lo, 15728880
s_mov_b32 exec_hi, 15728880
ds_read_b128 v[184:187], v39 offset:0
ds_read_b128 v[188:191], v39 offset:64
ds_read_b128 v[192:195], v39 offset:128
ds_read_b128 v[196:199], v39 offset:192
ds_read_b128 v[200:203], v39 offset:256
ds_read_b128 v[204:207], v39 offset:320
ds_read_b128 v[208:211], v39 offset:384
ds_read_b128 v[212:215], v39 offset:448
s_mov_b64 exec, -1
s_waitcnt lgkmcnt(0)
v_add_f32 v12, v12, v13
v_add_f32 v14, v14, v15
v_add_f32 v12, v12, v14
v_rcp_f32 v238, v12
v_log_f32 v12, v12
v_mov_b32 v13, 0x3fb8aa3b
v_fma_f32 v234, v236, v13, v12
v_mov_b32 v235, s60
buffer_load_dwordx2 v[228:229], v42, s[44:47], 0 offen sc1
L_sp16:
ds_read_b32 v12, v8 offset:88
s_waitcnt lgkmcnt(0)
v_cmp_ne_u32 vcc, 0, v12
s_cbranch_vccnz L_sp16_d
s_sleep 1
s_sub_u32 s68, s68, 1
s_cbranch_scc0 L_sp16
s_mov_b32 s68, 0
L_sp16_d:
ds_read_b64_tr_b16 v[88:89], v29 offset:0
ds_read_b64_tr_b16 v[90:91], v29 offset:1024
ds_read_b64_tr_b16 v[92:93], v30 offset:0
ds_read_b64_tr_b16 v[94:95], v30 offset:1024
ds_read_b64_tr_b16 v[96:97], v29 offset:8192
ds_read_b64_tr_b16 v[98:99], v29 offset:9216
ds_read_b64_tr_b16 v[100:101], v30 offset:8192
ds_read_b64_tr_b16 v[102:103], v30 offset:9216
ds_read_b64_tr_b16 v[104:105], v29 offset:16384
ds_read_b64_tr_b16 v[106:107], v29 offset:17408
s_waitcnt lgkmcnt(8)
v_mfma_f32_16x16x32_bf16 v[216:219], v[88:91], v[152:155], v[216:219]
ds_read_b64_tr_b16 v[108:109], v30 offset:16384
ds_read_b64_tr_b16 v[110:111], v30 offset:17408
s_waitcnt lgkmcnt(8)
v_mfma_f32_16x16x32_bf16 v[216:219], v[92:95], v[184:187], v[216:219]
ds_read_b64_tr_b16 v[112:113], v29 offset:24576
ds_read_b64_tr_b16 v[114:115], v29 offset:25600
s_waitcnt lgkmcnt(8)
v_mfma_f32_16x16x32_bf16 v[216:219], v[96:99], v[156:159], v[216:219]
ds_read_b64_tr_b16 v[116:117], v30 offset:24576
ds_read_b64_tr_b16 v[118:119], v30 offset:25600
s_waitcnt lgkmcnt(8)
v_mfma_f32_16x16x32_bf16 v[216:219], v[100:103], v[188:191], v[216:219]
ds_read_b64_tr_b16 v[120:121], v29 offset:32768
ds_read_b64_tr_b16 v[122:123], v29 offset:33792
s_waitcnt lgkmcnt(8)
v_mfma_f32_16x16x32_bf16 v[216:219], v[104:107], v[160:163], v[216:219]
ds_read_b64_tr_b16 v[124:125], v30 offset:32768
ds_read_b64_tr_b16 v[126:127], v30 offset:33792
s_waitcnt lgkmcnt(8)
v_mfma_f32_16x16x32_bf16 v[216:219], v[108:111], v[192:195], v[216:219]
ds_read_b64_tr_b16 v[128:129], v29 offset:40960
ds_read_b64_tr_b16 v[130:131], v29 offset:41984
s_waitcnt lgkmcnt(8)
v_mfma_f32_16x16x32_bf16 v[216:219], v[112:115], v[164:167], v[216:219]
ds_read_b64_tr_b16 v[132:133], v30 offset:40960
ds_read_b64_tr_b16 v[134:135], v30 offset:41984
s_waitcnt lgkmcnt(8)
v_mfma_f32_16x16x32_bf16 v[216:219], v[116:119], v[196:199], v[216:219]
s_waitcnt lgkmcnt(6)
v_mfma_f32_16x16x32_bf16 v[216:219], v[120:123], v[168:171], v[216:219]
s_waitcnt lgkmcnt(4)
v_mfma_f32_16x16x32_bf16 v[216:219], v[124:127], v[200:203], v[216:219]
s_waitcnt lgkmcnt(2)
v_mfma_f32_16x16x32_bf16 v[216:219], v[128:131], v[172:175], v[216:219]
s_waitcnt lgkmcnt(0)
v_mfma_f32_16x16x32_bf16 v[216:219], v[132:135], v[204:207], v[216:219]
s_barrier
ds_read_b64_tr_b16 v[136:137], v29 offset:49152
ds_read_b64_tr_b16 v[138:139], v29 offset:50176
ds_read_b64_tr_b16 v[140:141], v30 offset:49152
ds_read_b64_tr_b16 v[142:143], v30 offset:50176
ds_read_b64_tr_b16 v[144:145], v29 offset:57344
ds_read_b64_tr_b16 v[146:147], v29 offset:58368
ds_read_b64_tr_b16 v[148:149], v30 offset:57344
ds_read_b64_tr_b16 v[150:151], v30 offset:58368
s_waitcnt lgkmcnt(6)
v_mfma_f32_16x16x32_bf16 v[216:219], v[136:139], v[176:179], v[216:219]
s_waitcnt lgkmcnt(4)
v_mfma_f32_16x16x32_bf16 v[216:219], v[140:143], v[208:211], v[216:219]
s_waitcnt lgkmcnt(2)
v_mfma_f32_16x16x32_bf16 v[216:219], v[144:147], v[180:183], v[216:219]
s_waitcnt lgkmcnt(0)
v_mfma_f32_16x16x32_bf16 v[216:219], v[148:151], v[212:215], v[216:219]
s_mov_b32 exec_lo, 0x00ff00ff
s_mov_b32 exec_hi, 0x00ff00ff
s_cmp_eq_u32 s62, 0
s_nop 4
v_pk_mul_f32 v[216:217], v[216:217], v[238:239] op_sel_hi:[1,0]
v_pk_mul_f32 v[218:219], v[218:219], v[238:239] op_sel_hi:[1,0]
v_cvt_pk_bf16_f32 v232, v216, v217
v_cvt_pk_bf16_f32 v233, v218, v219
s_cbranch_scc0 L_po_st_g
buffer_store_dwordx4 v[232:235], v43, s[44:47], 0 offen sc0
L_po_st_e:
s_mov_b64 exec, -1
s_waitcnt vmcnt(1)
L_ph:
v_cmp_ne_u32 vcc, s60, v229
s_cbranch_vccnz L_ph_r
L_ph_d:
ds_write_b32 v49, v228
ds_read_b128 v[20:23], v37 offset:0
ds_read_b128 v[24:27], v37 offset:64
s_waitcnt lgkmcnt(1)
v_mfma_f32_16x16x32_bf16 v[220:223], v[72:75], v[20:23], v[220:223]
s_waitcnt lgkmcnt(0)
v_mfma_f32_16x16x32_bf16 v[220:223], v[76:79], v[24:27], v[220:223]
s_mov_b32 exec_lo, 0x00030003
s_mov_b32 exec_hi, 0x00030003
s_cmp_eq_u32 s62, 0
s_nop 4
v_add_u32 v220, 0x80, v220
v_add_u32 v221, 0x80, v221
v_add_u32 v222, 0x80, v222
v_add_u32 v223, 0x80, v223
v_perm_b32 v220, v220, v235, s20
v_perm_b32 v221, v221, v235, s21
v_perm_b32 v222, v222, v235, s22
v_perm_b32 v223, v223, v235, s23
s_cbranch_scc0 L_pfs_g
buffer_store_dwordx4 v[220:223], v45, s[44:47], s67 offen sc0
L_pfs_e:
s_mov_b64 exec, -1
buffer_load_dwordx4 v[56:59], v44, s[44:47], 0 offen offset:0 sc1
buffer_load_dwordx4 v[60:63], v44, s[44:47], 0 offen offset:512 sc1
buffer_load_dwordx4 v[64:67], v44, s[44:47], 0 offen offset:1024 sc1
buffer_load_dwordx4 v[68:71], v44, s[44:47], 0 offen offset:1536 sc1
v_mov_b32 v216, 0
v_mov_b32 v217, 0
v_mov_b32 v218, 0
v_mov_b32 v219, 0
s_barrier
ds_read_b64_tr_b16 v[152:153], v28 offset:0
ds_read_b64_tr_b16 v[154:155], v28 offset:512
ds_read_b64_tr_b16 v[156:157], v28 offset:4096
ds_read_b64_tr_b16 v[158:159], v28 offset:4608
ds_read_b64_tr_b16 v[160:161], v28 offset:8192
ds_read_b64_tr_b16 v[162:163], v28 offset:8704
ds_read_b64_tr_b16 v[164:165], v28 offset:12288
ds_read_b64_tr_b16 v[166:167], v28 offset:12800
s_branch L_po_w
L_po_r:
s_sub_u32 s68, s68, 1
s_cbranch_scc1 L_po_x
s_mov_b64 exec, s[8:9]
s_cbranch_execz L_po_s0
buffer_load_dwordx4 v[56:59], v44, s[44:47], 0 offen offset:0 sc1
L_po_s0:
s_mov_b64 exec, s[10:11]
s_cbranch_execz L_po_s1
buffer_load_dwordx4 v[60:63], v44, s[44:47], 0 offen offset:512 sc1
L_po_s1:
s_mov_b64 exec, s[12:13]
s_cbranch_execz L_po_s2
buffer_load_dwordx4 v[64:67], v44, s[44:47], 0 offen offset:1024 sc1
L_po_s2:
s_mov_b64 exec, s[14:15]
s_cbranch_execz L_po_s3
buffer_load_dwordx4 v[68:71], v44, s[44:47], 0 offen offset:1536 sc1
L_po_s3:
s_mov_b64 exec, -1
L_po_w:
s_waitcnt vmcnt(0)
v_cmp_ne_u32 s[8:9], s60, v59
v_cmp_ne_u32 s[10:11], s60, v63
v_cmp_ne_u32 s[12:13], s60, v67
v_cmp_ne_u32 s[14:15], s60, v71
s_or_b64 s[16:17], s[8:9], s[10:11]
s_or_b64 s[18:19], s[12:13], s[14:15]
s_or_b64 s[16:17], s[16:17], s[18:19]
s_cbranch_scc1 L_po_r
L_po_d:
v_max3_f32 v236, v58, v62, v66
v_max_f32 v236, v236, v70
v_mov_b32 v12, v236
v_lshlrev_b32 v72, 16, v56
v_lshlrev_b32 v76, 16, v60
v_permlane16_swap_b32 v236, v12
v_max_f32 v236, v236, v12
v_mov_b32 v12, v236
v_lshlrev_b32 v80, 16, v64
v_lshlrev_b32 v84, 16, v68
v_permlane32_swap_b32 v236, v12
v_max_f32 v236, v236, v12
v_sub_f32 v228, v58, v236
v_sub_f32 v229, v62, v236
v_sub_f32 v230, v66, v236
v_sub_f32 v231, v70, v236
v_exp_f32 v228, v228
v_and_b32 v73, 0xffff0000, v56
v_lshlrev_b32 v74, 16, v57
v_and_b32 v75, 0xffff0000, v57
v_exp_f32 v229, v229
v_and_b32 v77, 0xffff0000, v60
v_lshlrev_b32 v78, 16, v61
v_and_b32 v79, 0xffff0000, v61
v_exp_f32 v230, v230
v_and_b32 v81, 0xffff0000, v64
v_lshlrev_b32 v82, 16, v65
v_and_b32 v83, 0xffff0000, v65
v_exp_f32 v231, v231
v_and_b32 v85, 0xffff0000, v68
v_lshlrev_b32 v86, 16, v69
v_and_b32 v87, 0xffff0000, v69
v_pk_mul_f32 v[240:241], v[72:73], v[228:229] op_sel_hi:[1,0]
v_pk_mul_f32 v[242:243], v[74:75], v[228:229] op_sel_hi:[1,0]
v_pk_add_f32 v[244:245], v[228:229], v[230:231]
v_pk_fma_f32 v[240:241], v[76:77], v[228:229], v[240:241] op_sel:[0,1,0] op_sel_hi:[1,1,1]
v_pk_fma_f32 v[242:243], v[78:79], v[228:229], v[242:243] op_sel:[0,1,0] op_sel_hi:[1,1,1]
v_add_f32 v244, v244, v245
v_pk_fma_f32 v[240:241], v[80:81], v[230:231], v[240:241] op_sel_hi:[1,0,1]
v_pk_fma_f32 v[242:243], v[82:83], v[230:231], v[242:243] op_sel_hi:[1,0,1]
v_mov_b32 v245, v244
v_pk_fma_f32 v[240:241], v[84:85], v[230:231], v[240:241] op_sel:[0,1,0] op_sel_hi:[1,1,1]
v_pk_fma_f32 v[242:243], v[86:87], v[230:231], v[242:243] op_sel:[0,1,0] op_sel_hi:[1,1,1]
v_permlane32_swap_b32 v244, v245
v_permlane32_swap_b32 v240, v241
v_permlane32_swap_b32 v242, v243
v_add_f32 v244, v244, v245
v_add_f32 v240, v240, v241
v_add_f32 v242, v242, v243
v_mov_b32 v245, v244
s_nop 0
v_permlane16_swap_b32 v240, v242
v_permlane16_swap_b32 v244, v245
v_add_f32 v244, v244, v245
v_add_f32 v240, v240, v242
v_rcp_f32 v244, v244
s_nop 0
v_mul_f32 v240, v240, v244
v_cvt_pk_bf16_f32 v240, v240, v240
ds_write_b16 v50, v240
s_waitcnt lgkmcnt(0)
s_barrier
ds_read_b128 v[88:91], v36 offset:0
ds_read_b128 v[92:95], v36 offset:64
ds_read_b128 v[96:99], v36 offset:128
ds_read_b128 v[100:103], v36 offset:192
s_waitcnt lgkmcnt(3)
v_mfma_f32_16x16x32_bf16 v[216:219], v[152:155], v[88:91], v[216:219]
s_waitcnt lgkmcnt(2)
v_mfma_f32_16x16x32_bf16 v[216:219], v[156:159], v[92:95], v[216:219]
s_waitcnt lgkmcnt(1)
v_mfma_f32_16x16x32_bf16 v[216:219], v[160:163], v[96:99], v[216:219]
s_waitcnt lgkmcnt(0)
v_mfma_f32_16x16x32_bf16 v[216:219], v[164:167], v[100:103], v[216:219]
s_mov_b32 exec_lo, 0x00030003
s_mov_b32 exec_hi, 0x00030003
s_nop 5
v_perm_b32 v216, v216, v235, s20
v_perm_b32 v217, v217, v235, s21
v_perm_b32 v218, v218, v235, s22
v_perm_b32 v219, v219, v235, s23
buffer_store_dwordx4 v[216:219], v45, s[44:47], s66 offen sc1
s_waitcnt vmcnt(0)
s_barrier
s_endpgm
L_pf_x:
s_mov_b32 s68, 0
s_branch L_pf_d
L_ps_x:
s_mov_b32 s68, 0
s_branch L_ps_d
L_pq_x:
s_mov_b32 s68, 0
s_branch L_pq_d
L_pr_x:
s_mov_b32 s68, 0
s_branch L_pr_d
L_po_st_g:
buffer_store_dwordx4 v[232:235], v43, s[44:47], 0 offen sc1
s_branch L_po_st_e
L_ph_r:
buffer_load_dwordx2 v[228:229], v42, s[44:47], 0 offen sc1
s_sub_u32 s68, s68, 1
s_waitcnt vmcnt(0)
s_cbranch_scc0 L_ph
s_mov_b32 s68, 0
s_branch L_ph_d
L_pfs_g:
buffer_store_dwordx4 v[220:223], v45, s[44:47], s67 offen sc1
s_branch L_pfs_e
L_po_x:
s_mov_b32 s68, 0
s_branch L_po_d
.section .rodata,"a"
.p2align 6
.amdhsa_kernel recurrent_scan__sliding_block_cached__swiglu_ffn__decode_kernel
  .amdhsa_next_free_vgpr 246
  .amdhsa_next_free_sgpr 102
  .amdhsa_accum_offset 248
  .amdhsa_group_segment_fixed_size 0
  .amdhsa_kernarg_size 96
  .amdhsa_user_sgpr_count 2
  .amdhsa_user_sgpr_kernarg_segment_ptr 1
  .amdhsa_system_sgpr_workgroup_id_x 1
.end_amdhsa_kernel
.text
```
